```python
import torch

def _softmax(x, axis=-1):
    return torch.softmax(x, dim=axis)
def _gelu(x):
    return torch.nn.functional.gelu(x, approximate="tanh")
def _silu(x):
    return torch.nn.functional.silu(x)
def _sigmoid(x):
    return torch.sigmoid(x)
def _layernorm(x, axis=-1, eps=1e-5):
    m = x.mean(dim=axis, keepdim=True)
    v = x.var(dim=axis, keepdim=True, unbiased=False)
    return (x - m) / torch.sqrt(v + eps)
def _scatter_add(tgt, idx, src, axis=0):
    return tgt.clone().index_add_(axis, idx, src)
def _segment_sum(src, seg, n):
    out = torch.zeros((n,) + src.shape[1:], dtype=src.dtype)
    return out.index_add_(0, seg, src)
def _pad(x, pw):
    flat = tuple(v for pair in reversed(pw) for v in pair)
    return torch.nn.functional.pad(x, flat)

kernel_name = 'recurrent_scan__sliding_block_cached__dense_activation_relu__decode'

def setup_inputs():

    _w = (lambda a: (lambda t: t.to(torch.bfloat16) if t.is_floating_point() else t)(torch.as_tensor(a)))
    def _A_setup():
        B, Sq, D = 4, 1, 512
        Hq, Hkv, Sk, Dh = 32, 8, 8192, 128
        assert Hq % Hkv == 0, (Hq, Hkv)
        return {
            "x": _w((lambda *s: torch.randn(*s, dtype=torch.bfloat16) * 0.05)(B, Sq, D)),
            "k_cache": _w((lambda *s: torch.randn(*s, dtype=torch.bfloat16) * 1.6)(B, Hkv, Sk, Dh)),
            "v_cache": _w((lambda *s: torch.randn(*s, dtype=torch.bfloat16) * 0.2)(B, Hkv, Sk, Dh)),
            "wq": _w((lambda *s: torch.randn(*s, dtype=torch.bfloat16) * 1.6)(D, Hq * Dh) * (D ** -0.5)),
            "wo": _w((lambda *s: torch.randn(*s, dtype=torch.bfloat16) * 0.2)(Hq * Dh, D) * ((Hq * Dh) ** -0.5)),
        }
    _A_in = _A_setup()

    def _B_setup():
        B, S, D, Dff = 4, 1, 512, 1792
        return {
            "x": _w((lambda *s: torch.randn(*s, dtype=torch.bfloat16) * 0.05)(B, S, D)),
            "w1": _w((lambda *s: torch.randn(*s, dtype=torch.bfloat16) * 0.1)(D, Dff)),
            "w2": _w((lambda *s: torch.randn(*s, dtype=torch.bfloat16) * 0.1)(Dff, D)),
        }
    _B_in = _B_setup()

    return {
        "A_x": _A_in["x"],
        "A_k_cache": _A_in["k_cache"],
        "A_v_cache": _A_in["v_cache"],
        "A_wq": _A_in["wq"],
        "A_wo": _A_in["wo"],
        "B_x": _B_in["x"],
        "B_w1": _B_in["w1"],
        "B_w2": _B_in["w2"],
    }

def reference(A_x, A_k_cache, A_v_cache, A_wq, A_wo, B_x, B_w1, B_w2):
    def _A_ref(x, k_cache, v_cache, wq, wo):
        B, Sq, D = x.shape
        Hq, Dh = 32, 128
        Hkv, Sk = k_cache.shape[1], k_cache.shape[2]
        W = min(4096, max(256, Sk // 4))
        rep = Hq // Hkv
        q = (lambda x, *d: x.permute(*d))((x @ wq).reshape(B, Sq, Hq, Dh), 0, 2, 1, 3)
        k = (lambda x, n, axis: torch.repeat_interleave(x, n, dim=axis))(k_cache[:, :, Sk - W:, :], rep, axis=1)
        v = (lambda x, n, axis: torch.repeat_interleave(x, n, dim=axis))(v_cache[:, :, Sk - W:, :], rep, axis=1)
        scores = torch.einsum("bhqd,bhkd->bhqk", q, k) * (Dh ** -0.5)
        p = _softmax(scores, axis=-1)
        o = torch.einsum("bhqk,bhkd->bhqd", p, v)
        return (lambda x, *d: x.permute(*d))(o, 0, 2, 1, 3).reshape(B, Sq, Hq * Dh) @ wo

    def _B_ref(x, w1, w2):
        h = torch.einsum("bsd,df->bsf", x, w1)
        zero = torch.zeros_like(h)
        h = torch.maximum(h, zero)
        return torch.einsum("bsf,fd->bsd", h, w2)

    x = A_x
    xn = _layernorm(x, axis=-1)
    s = _A_ref(xn, A_k_cache, A_v_cache, A_wq, A_wo)
    g = _silu(_B_ref(xn, B_w1, B_w2))
    return x + s * g
```

```asm
; @launch grid=(256,1,1) block=(256,1,1) lds=163840
.amdgcn_target "amdgcn-amd-amdhsa--gfx950"
.text
.globl recurrent_scan__sliding_block_cached__dense_activation_relu__decode_kernel
.p2align 8
.type recurrent_scan__sliding_block_cached__dense_activation_relu__decode_kernel,@function
recurrent_scan__sliding_block_cached__dense_activation_relu__decode_kernel:
    s_load_dwordx16 s[36:51], s[0:1], 0
    s_load_dwordx4 s[72:75], s[0:1], 72
    s_getpc_b64 s[80:81]
    v_mad_u64_u32 v[162:163], vcc, v0, 36, s[80:81]
    s_cmpk_ge_u32 s2, 256
    s_cbranch_scc1 L_end
    global_load_dword v162, v[162:163], off
    v_readfirstlane_b32 s52, v0
    v_lshrrev_b32 v9, 3, v0
    v_lshlrev_b32 v8, 4, v0
    v_bitop3_b32 v10, v9, v0, 7 bitop3:0x28
    s_and_b32 s53, s2, 7
    s_lshr_b32 s56, s2, 5
    s_lshl3_add_u32 s81, s53, s56
    s_and_b32 s80, s2, 24
    s_lshl_b32 s80, s80, 10
    s_add_u32 s81, s81, s80
    s_lshl_b32 s81, s81, 7
    v_lshl_add_u32 v11, v9, 9, v10
    s_bfm_b32 s82, 8, 10
    v_lshl_add_u32 v11, v11, 4, s81
    s_lshl_b32 m0, s52, 6
    v_add_u32 v12, s82, v11
    v_add_u32 v13, s82, v12
    v_add_u32 v18, s82, v13
    s_and_b32 s58, s2, 31
    s_lshl_b32 s58, s58, 5
    s_add_u32 s58, s58, s56
    s_addk_i32 s58, 24
    s_lshl_b32 s58, s58, 16
    s_lshl1_add_u32 s58, s80, s58
    s_movk_i32 s82, 3072
    v_add_u32 v14, s58, v8
    v_xad_u32 v15, v14, 16, s82
    v_xad_u32 v16, v15, 48, s82
    s_waitcnt lgkmcnt(0)
    global_load_dwordx4 v[20:23], v8, s[36:37]
    s_load_dword s60, s[74:75], 0
    global_load_lds_dwordx4 v11, s[42:43] nt
    global_load_lds_dwordx4 v12, s[42:43] offset:1024 nt
    global_load_lds_dwordx4 v13, s[42:43] offset:2048 nt
    global_load_lds_dwordx4 v18, s[42:43] offset:3072 nt
    s_bitset1_b32 m0, 16
    v_xad_u32 v17, v16, 16, s82
    global_load_lds_dwordx4 v14, s[38:39] nt
    global_load_lds_dwordx4 v15, s[38:39] offset:1024 nt
    global_load_lds_dwordx4 v16, s[38:39] offset:2048 nt
    global_load_lds_dwordx4 v17, s[38:39] offset:3072 nt
L_head_end:
    s_load_dwordx2 s[32:33], s[0:1], 64
    s_lshl_b32 s59, s52, 6
    s_lshr_b32 s52, s52, 6
    s_bfe_u32 s55, s2, 0x20003
    s_getreg_b32 s70, hwreg(HW_REG_XCC_ID, 0, 4)
    s_lshl_b32 s92, s53, 5
    s_lshr_b32 s93, s2, 3
    s_add_u32 s93, s93, s92
    s_lshl_b32 s71, s93, 2
    s_lshl_b32 s92, s92, 2
L_nox:
    v_lshlrev_b32 v10, 4, v10
    s_mov_b32 s26, 1835008
    s_mov_b32 s27, 0x20000
    s_mov_b32 s57, 0
    s_cmp_gt_u32 s53, 7
    s_subb_u32 s91, s53, 0
    s_and_b32 s76, s56, 3
    s_lshl2_add_u32 s76, s91, s76
    s_xor_b32 s76, s76, 2
    s_xor_b32 s67, s56, 2
    s_bfe_u32 s68, s2, 0x30003
    s_bfe_u32 s77, s2, 0x10006
    s_lshl1_add_u32 s77, s91, s77
    s_lshl2_add_u32 s90, s77, s52
    s_cmp_eq_u32 s53, 7
    s_cbranch_scc1 L_now3
    s_cmp_lt_u32 s2, 128
    s_cbranch_scc1 L_now1
    s_mov_b32 s57, 1
    s_mov_b64 s[24:25], s[48:49]
    v_mul_u32_u24 v12, 3584, v9
    s_mul_i32 s83, s55, 3584
    s_add_u32 s83, s83, s76
    s_lshl_b32 s83, s83, 7
    v_add_u32 v12, v12, v10
    s_add_u32 m0, s59, 131072
    s_nop 0
    buffer_load_dwordx4 v12, s[24:27], s83 offen offset:0 nt lds
    s_add_i32 s83, s83, 113664
    buffer_load_dwordx4 v12, s[24:27], s83 offen offset:1024 nt lds
    s_add_i32 s83, s83, 113664
    buffer_load_dwordx4 v12, s[24:27], s83 offen offset:2048 nt lds
    s_add_i32 s83, s83, 113664
    buffer_load_dwordx4 v12, s[24:27], s83 offen offset:3072 nt lds
    s_branch L_now2
L_now1:
    s_mov_b32 s57, 2
    s_mov_b64 s[24:25], s[50:51]
    v_bfe_u32 v7, v9, 2, 1
    v_and_b32 v13, 2, v9
    v_add_u32 v13, v13, v7
    v_and_b32 v18, 1, v9
    v_lshl_add_u32 v13, v13, 1, v18
    s_lshl_b32 s91, s90, 8
    s_add_u32 s91, s91, s68
    s_lshl_b32 s91, s91, 7
    v_lshl_add_u32 v188, v13, 10, v10
L_now3:
    v_xor_b32 v14, 16448, v14
    v_xor_b32 v15, 16448, v15
    v_xor_b32 v16, 16448, v16
    v_xor_b32 v17, 16448, v17
    s_add_u32 m0, s59, 81920
    s_nop 0
    global_load_lds_dwordx4 v14, s[38:39] offset:0 nt
    global_load_lds_dwordx4 v15, s[38:39] offset:1024 nt
L_now2:
    v_and_b32 v1, 63, v0
    s_add_u32 s58, s58, s59
    v_lshrrev_b32 v3, 4, v1
    s_mov_b64 s[4:5], s[36:37]
    s_mov_b32 s6, 4096
    s_mov_b32 s7, 0x20000
    s_cmp_eq_u32 s57, 1
    s_cbranch_scc1 L_k1a
    s_branch L_k1b
L_k1a:
L_k1b:
    s_mov_b64 s[16:17], s[40:41]
    s_mov_b32 s18, 0x4000000
    s_mov_b32 s19, 0x20000
    s_mov_b64 s[20:21], s[44:45]
    s_mov_b32 s22, 0x400000
    s_mov_b32 s23, 0x20000
    s_mov_b64 s[28:29], s[74:75]
    s_mov_b32 s30, 1441792
    s_mov_b32 s31, 0x20000
    s_mov_b32 s34, 4096
    s_mov_b32 s35, 0x20000
    s_mov_b32 s78, 0
    v_and_b32 v2, 15, v1
    v_and_b32 v4, 3, v1
    v_bfe_u32 v5, v1, 2, 2
    v_mov_b32 v6, 0xff
    s_mul_i32 s80, s52, 1088
    s_add_u32 s80, s80, 147456
    v_lshl_add_u32 v24, v1, 4, s80
    s_lshl_b32 s80, s55, 8
    s_add_u32 s80, s80, 147456
    v_mul_u32_u24 v25, 1088, v5
    v_and_b32 v7, 1, v3
    v_lshl_add_u32 v25, v7, 3, v25
    v_and_b32 v7, 2, v3
    v_lshl_add_u32 v25, v7, 5, v25
    v_add_u32 v25, s80, v25
    v_bfe_u32 v7, v9, 2, 1
    v_and_b32 v13, 3, v9
    v_lshl_add_u32 v13, v7, 4, v13
    v_lshl_add_u32 v13, v13, 10, v10
    v_lshl_add_u32 v7, v3, 2, v5
    v_and_b32 v9, 7, v7
    v_lshlrev_b32 v9, 1, v9
    v_xor_b32 v9, v9, v4
    v_lshlrev_b32 v9, 3, v9
    v_lshl_add_u32 v9, v7, 7, v9
    s_lshl_b32 s80, s52, 5
    v_xor_b32 v26, s80, v9
    v_add_u32 v146, 131072, v26
    s_add_u32 s80, s59, 114688
    v_add_u32 v148, s80, v9
    v_xor_b32 v149, 32, v148
    v_xor_b32 v150, 64, v148
    v_xor_b32 v151, 0x60, v148
    v_lshlrev_b32 v7, 2, v2
    v_lshl_add_u32 v29, v3, 13, v7
    v_lshl_add_u32 v30, v3, 10, v7
    v_lshl_add_u32 v7, v3, 8, v7
    s_lshl_b32 s80, s52, 10
    s_add_u32 s80, s80, 155648
    v_add_u32 v147, s80, v7
    v_add_u32 v161, 4096, v147
    s_lshl_b32 s84, s53, 4
    s_add_u32 s84, s84, s55
    s_lshl_b32 s84, s84, 3
    s_add_u32 s84, s84, s56
    s_lshl_b32 s84, s84, 2
    s_add_u32 s84, s84, s52
    s_lshl_b32 s84, s84, 6
    s_add_u32 s84, s84, 4096
    s_lshl_b32 s85, s76, 1
    s_lshr_b32 s80, s52, 1
    s_add_u32 s85, s85, s80
    s_lshl_b32 s85, s85, 5
    s_add_u32 s85, s85, s55
    s_lshl_b32 s85, s85, 1
    s_and_b32 s81, s52, 1
    s_add_u32 s85, s85, s81
    s_lshl_b32 s85, s85, 6
    s_add_u32 s85, s85, 266240
    s_cmp_eq_u32 s52, 3
    s_cselect_b32 s93, 0, 0
    s_cmp_eq_u32 s57, 1
    s_cselect_b32 s80, 4, 2
    s_add_u32 s93, s80, s93
    s_cmp_gt_u32 s93, 2
    s_cbranch_scc1 L_xw_2
    s_waitcnt vmcnt(10)
L_xw_2:
    s_waitcnt vmcnt(12)
    v_lshlrev_b32 v32, 16, v20
    v_and_b32 v33, 0xffff0000, v20
    v_lshlrev_b32 v34, 16, v21
    v_and_b32 v35, 0xffff0000, v21
    v_lshlrev_b32 v36, 16, v22
    v_and_b32 v37, 0xffff0000, v22
    v_lshlrev_b32 v38, 16, v23
    v_and_b32 v39, 0xffff0000, v23
    v_readfirstlane_b32 s80, v32
    s_nop 1
    v_subrev_f32 v44, s80, v32
    v_subrev_f32 v45, s80, v33
    v_subrev_f32 v46, s80, v34
    v_subrev_f32 v47, s80, v35
    v_subrev_f32 v48, s80, v36
    v_subrev_f32 v49, s80, v37
    v_subrev_f32 v50, s80, v38
    v_subrev_f32 v51, s80, v39
    v_add_f32 v40, v44, v45
    v_mul_f32 v42, v44, v44
    v_add_f32 v41, v46, v47
    v_mul_f32 v43, v45, v45
    v_fmac_f32 v42, v46, v46
    v_fmac_f32 v43, v47, v47
    v_fmac_f32 v42, v48, v48
    v_add_f32 v40, v40, v48
    v_fmac_f32 v43, v49, v49
    v_add_f32 v41, v41, v49
    v_fmac_f32 v42, v50, v50
    v_add_f32 v40, v40, v50
    v_fmac_f32 v43, v51, v51
    v_add_f32 v41, v41, v51
    v_add_f32 v40, v40, v41
    v_add_f32 v42, v42, v43
    s_nop 0
    v_add_f32_dpp v40, v40, v40 quad_perm:[1,0,3,2] row_mask:0xf bank_mask:0xf
    v_add_f32_dpp v42, v42, v42 quad_perm:[1,0,3,2] row_mask:0xf bank_mask:0xf
    s_nop 0
    v_add_f32_dpp v40, v40, v40 quad_perm:[2,3,0,1] row_mask:0xf bank_mask:0xf
    v_add_f32_dpp v42, v42, v42 quad_perm:[2,3,0,1] row_mask:0xf bank_mask:0xf
    s_nop 0
    v_add_f32_dpp v40, v40, v40 row_half_mirror row_mask:0xf bank_mask:0xf
    v_add_f32_dpp v42, v42, v42 row_half_mirror row_mask:0xf bank_mask:0xf
    s_nop 0
    v_add_f32_dpp v40, v40, v40 row_mirror row_mask:0xf bank_mask:0xf
    v_add_f32_dpp v42, v42, v42 row_mirror row_mask:0xf bank_mask:0xf
    v_mov_b32 v41, v40
    v_mov_b32 v43, v42
    s_nop 0
    v_permlane16_swap_b32 v40, v41
    v_permlane16_swap_b32 v42, v43
    v_add_f32 v40, v40, v41
    v_add_f32 v42, v42, v43
    v_mov_b32 v41, v40
    v_mov_b32 v43, v42
    s_nop 0
    v_permlane32_swap_b32 v40, v41
    v_permlane32_swap_b32 v42, v43
    v_add_f32 v40, v40, v41
    v_add_f32 v42, v42, v43
    v_mul_f32 v40, 0x3b000000, v40
    v_mul_f32 v42, 0x3b000000, v42
    v_fma_f32 v42, -v40, v40, v42
    v_add_f32 v40, s80, v40
    v_max_f32 v42, 0, v42
    v_cvt_pk_bf16_f32 v41, v40, v42
    v_lshlrev_b32 v40, 16, v41
    v_and_b32 v42, 0xffff0000, v41
    v_add_f32 v42, 0x3727c5ac, v42
    v_cvt_pk_bf16_f32 v42, v42, v42
    v_and_b32 v42, 0xffff0000, v42
    v_sqrt_f32 v42, v42
    v_sub_f32 v32, v32, v40
    v_sub_f32 v33, v33, v40
    v_sub_f32 v34, v34, v40
    v_sub_f32 v35, v35, v40
    v_sub_f32 v36, v36, v40
    v_sub_f32 v37, v37, v40
    v_sub_f32 v38, v38, v40
    v_sub_f32 v39, v39, v40
    v_cvt_pk_bf16_f32 v42, v42, v42
    v_and_b32 v42, 0xffff0000, v42
    v_rcp_f32 v42, v42
    v_cvt_pk_bf16_f32 v44, v32, v33
    v_lshlrev_b32 v32, 16, v44
    v_and_b32 v33, 0xffff0000, v44
    v_cvt_pk_bf16_f32 v45, v34, v35
    v_lshlrev_b32 v34, 16, v45
    v_and_b32 v35, 0xffff0000, v45
    v_cvt_pk_bf16_f32 v46, v36, v37
    v_lshlrev_b32 v36, 16, v46
    v_and_b32 v37, 0xffff0000, v46
    v_cvt_pk_bf16_f32 v47, v38, v39
    v_lshlrev_b32 v38, 16, v47
    v_and_b32 v39, 0xffff0000, v47
    v_mul_f32 v32, v32, v42
    v_mul_f32 v33, v33, v42
    v_mul_f32 v34, v34, v42
    v_mul_f32 v35, v35, v42
    v_mul_f32 v36, v36, v42
    v_mul_f32 v37, v37, v42
    v_mul_f32 v38, v38, v42
    v_mul_f32 v39, v39, v42
    v_cvt_pk_bf16_f32 v44, v32, v33
    v_cvt_pk_bf16_f32 v45, v34, v35
    v_cvt_pk_bf16_f32 v46, v36, v37
    v_cvt_pk_bf16_f32 v47, v38, v39
    ds_write_b128 v24, v[44:47]
    s_cmp_eq_u32 s57, 1
    s_cbranch_scc1 L_k2a
    s_add_u32 m0, s59, 81920
    s_nop 0
    global_load_lds_dwordx4 v16, s[38:39] offset:2048 nt
    s_branch L_k2b
L_k2a:
    v_xor_b32 v14, 16448, v14
    v_xor_b32 v15, 16448, v15
    v_xor_b32 v16, 16448, v16
    v_xor_b32 v17, 16448, v17
    s_add_u32 m0, s59, 81920
    s_nop 0
    global_load_lds_dwordx4 v14, s[38:39] offset:0 nt
L_k2b:
    s_waitcnt lgkmcnt(0)
    s_add_u32 s60, s60, 0x9d5b3701
    s_and_b32 s61, s60, 0xff
    s_bfe_u32 s62, s60, 0x80008
    s_bfe_u32 s63, s60, 0x80010
    s_lshr_b32 s64, s60, 24
    v_lshlrev_b32 v7, 3, v4
    v_lshrrev_b32 v141, v7, s60
    s_xor_b32 s70, s70, s60
    v_mov_b32 v19, s70
    s_mov_b64 exec, 1
    buffer_store_dword v19, off, s[28:31], s71 offset:1024
    s_mov_b64 exec, -1
    s_cmp_gt_u32 s93, 2
    s_cbranch_scc1 L_wqw_2
    s_waitcnt vmcnt(8)
L_wqw_2:
    s_waitcnt vmcnt(10)
    s_barrier
    ds_read2_b64 v[32:35], v25 offset0:0 offset1:16
    ds_read2_b64 v[36:39], v25 offset0:2 offset1:18
    ds_read2_b64 v[40:43], v25 offset0:4 offset1:20
    ds_read2_b64 v[44:47], v25 offset0:6 offset1:22
    ds_read_b64_tr_b16 v[48:49], v26 offset:0
    ds_read_b64_tr_b16 v[50:51], v26 offset:2048
    ds_read_b64_tr_b16 v[52:53], v26 offset:4096
    ds_read_b64_tr_b16 v[54:55], v26 offset:6144
    ds_read_b64_tr_b16 v[56:57], v26 offset:8192
    ds_read_b64_tr_b16 v[58:59], v26 offset:10240
    ds_read_b64_tr_b16 v[60:61], v26 offset:12288
    ds_read_b64_tr_b16 v[62:63], v26 offset:14336
    s_waitcnt lgkmcnt(6)
    v_mfma_f32_16x16x32_bf16 v[64:67], v[32:35], v[48:51], 0
    s_waitcnt lgkmcnt(4)
    v_mfma_f32_16x16x32_bf16 v[64:67], v[36:39], v[52:55], v[64:67]
    s_waitcnt lgkmcnt(2)
    v_mfma_f32_16x16x32_bf16 v[64:67], v[40:43], v[56:59], v[64:67]
    s_waitcnt lgkmcnt(0)
    v_mfma_f32_16x16x32_bf16 v[64:67], v[44:47], v[60:63], v[64:67]
    s_nop 7
    v_bfi_b32 v190, v6, v141, v64
    buffer_store_dword v190, v29, s[28:31], s84 offen
    v_lshlrev_b32 v189, 2, v0
    v_add_u32 v189, 155648, v189
    ds_write_b32 v189, v190
    s_and_b32 s44, s60, 0xffffff00
    s_lshl_b32 s45, s67, 1
    s_add_u32 s45, s45, s52
    s_lshl_b32 s45, s45, 7
    s_add_u32 s45, s45, 1792
    s_lshl_b32 s80, s2, 2
    s_add_u32 s80, s80, s52
    s_cmp_eq_u32 s80, 1021
    s_cbranch_scc0 L_notk
    v_mov_b32 v69, s44
    v_lshlrev_b32 v70, 7, v1
    s_mov_b64 exec, 0xffff
    buffer_store_dword v69, v70, s[28:31], 0 offen offset:2048 sc1
    s_mov_b64 exec, -1
L_notk:
    s_cmp_eq_u32 s57, 1
    s_cbranch_scc1 L_k3a
    s_add_u32 m0, s59, 81920
    s_nop 0
    global_load_lds_dwordx4 v17, s[38:39] offset:3072 nt
    v_xor_b32 v14, 49344, v14
    v_xor_b32 v15, 49344, v15
    v_xor_b32 v16, 49344, v16
    v_xor_b32 v17, 49344, v17
    s_add_u32 m0, s59, 98304
    s_nop 0
    global_load_lds_dwordx4 v14, s[38:39] offset:0 nt
    global_load_lds_dwordx4 v15, s[38:39] offset:1024 nt
    global_load_lds_dwordx4 v16, s[38:39] offset:2048 nt
    global_load_lds_dwordx4 v17, s[38:39] offset:3072 nt
    s_branch L_k3b
L_k3a:
    s_add_u32 m0, s59, 81920
    s_nop 0
    global_load_lds_dwordx4 v15, s[38:39] offset:1024 nt
    global_load_lds_dwordx4 v16, s[38:39] offset:2048 nt
    global_load_lds_dwordx4 v17, s[38:39] offset:3072 nt
    v_xor_b32 v14, 49344, v14
    v_xor_b32 v15, 49344, v15
    v_xor_b32 v16, 49344, v16
    v_xor_b32 v17, 49344, v17
    s_add_u32 m0, s59, 98304
    s_nop 0
    global_load_lds_dwordx4 v14, s[38:39] offset:0 nt
    global_load_lds_dwordx4 v15, s[38:39] offset:1024 nt
L_k3b:
    v_lshl_add_u32 v7, v3, 2, v5
    v_and_b32 v9, 7, v7
    s_lshl_b32 s80, s52, 1
    v_xor_b32 v9, s80, v9
    v_lshlrev_b32 v9, 5, v9
    v_lshl_add_u32 v9, v7, 8, v9
    v_lshl_add_u32 v27, v4, 3, v9
    v_xor_b32 v28, 32, v27
    v_lshlrev_b32 v7, 1, v3
    v_xor_b32 v144, v2, v7
    v_lshlrev_b32 v144, 4, v144
    v_lshl_add_u32 v144, v3, 8, v144
    v_xor_b32 v145, 0x80, v144
    s_lshl4_add_u32 s80, s52, 153216
    v_mul_u32_u24 v10, 576, v3
    v_and_b32 v7, 14, v2
    v_lshl_add_u32 v10, v7, 5, v10
    v_and_b32 v7, 1, v2
    v_lshl_add_u32 v10, v7, 3, v10
    v_add_u32 v10, s80, v10
    v_mul_u32_u24 v11, 576, v5
    v_lshl_add_u32 v11, v3, 4, v11
    v_add_u32 v11, 153216, v11
    v_lshlrev_b32 v31, 4, v2
    v_lshl_add_u32 v31, v3, 11, v31
    s_lshl_b32 s86, s53, 2
    s_add_u32 s86, s86, s55
    s_lshl_b32 s87, s86, 4
    s_add_u32 s87, s87, s52
    s_lshl_b32 s87, s87, 9
    s_add_u32 s87, s87, 4096
    s_lshl_b32 s88, s86, 2
    s_add_u32 s88, s88, s52
    s_lshl_b32 s89, s88, 8
    s_add_u32 s89, s89, s67
    s_lshl_b32 s89, s89, 7
    s_lshl_b32 s88, s88, 12
    s_add_u32 s88, s88, 524288
    s_lshl_b32 s90, s90, 12
    s_add_u32 s90, s90, 266240
    v_xor_b32 v7, v3, v2
    v_lshlrev_b32 v7, 4, v7
    v_lshl_add_u32 v7, v4, 10, v7
    v_lshl_add_u32 v7, v5, 14, v7
    s_add_u32 s80, s59, 65536
    v_add_u32 v152, s80, v7
    v_xor_b32 v153, 64, v152
    v_xor_b32 v154, 0x80, v152
    v_xor_b32 v155, 0xc0, v152
    v_lshrrev_b32 v7, 1, v3
    v_and_b32 v9, 1, v3
    v_lshlrev_b32 v7, 7, v7
    v_lshl_add_u32 v7, v2, 3, v7
    v_lshl_add_u32 v7, v9, 2, v7
    s_mul_i32 s80, s52, 320
    s_add_u32 s80, s80, 151808
    v_add_u32 v156, s80, v7
    v_mul_u32_u24 v157, 320, v5
    v_lshl_add_u32 v157, v3, 4, v157
    v_add_u32 v157, 151808, v157
    v_lshlrev_b32 v8, 4, v3
    v_add_u32 v8, 153088, v8
    s_lshl_b32 s80, s52, 2
    v_add_u32 v9, s80, v8
    v_lshlrev_b32 v12, 4, v4
    v_lshl_add_u32 v12, v3, 7, v12
    v_lshl_add_u32 v12, v5, 10, v12
    v_lshlrev_b32 v158, 3, v2
    v_lshl_add_u32 v158, v3, 14, v158
    v_and_b32 v7, 1, v4
    v_lshl_add_u32 v159, v7, 2, v3
    v_lshl_add_u32 v159, v5, 3, v159
    v_lshlrev_b32 v159, 4, v159
    v_mov_b32 v160, 0
    s_lshl_b32 s80, s55, 3
    s_add_u32 s80, s80, s56
    s_lshl_b32 s81, s53, 2
    s_add_u32 s81, s81, s52
    s_lshl_b32 s81, s81, 5
    s_add_u32 s81, s81, s80
    s_lshl_b32 s81, s81, 4
    s_add_u32 s36, s81, 495616
    s_lshl_b32 s37, s53, 16
    s_add_u32 s37, s37, s59
    s_lshl_b32 s80, s80, 7
    s_add_u32 s37, s37, s80
    s_add_u32 s37, s37, 524288
    s_lshl_b32 s46, s86, 9
    s_add_u32 s46, s46, 495616
    v_lshlrev_b32 v164, 4, v1
    v_add_u32 v165, 155648, v164
    v_and_b32 v18, 7, v2
    v_bfe_u32 v19, v1, 3, 1
    v_lshl_add_u32 v19, v3, 4, v19
    v_mul_u32_u24 v19, 6144, v19
    v_lshl_add_u32 v166, v18, 4, v19
    v_lshl_add_u32 v18, v18, 2, v3
    v_lshlrev_b32 v167, 1, v18
    s_mul_i32 s47, s67, 12288
    s_lshl_b32 s80, s86, 7
    s_add_u32 s47, s47, s80
    s_add_u32 s47, s47, 1048576
    s_mul_i32 s40, s68, 12288
    s_lshl_b32 s80, s77, 7
    s_add_u32 s40, s40, s80
    s_add_u32 s40, s40, 1052672
    s_sub_u32 s41, s2, 192
    s_mul_i32 s42, s41, 6144
    s_add_u32 s42, s42, 1048576
    s_add_u32 s43, s42, 4096
    s_lshl_b32 s83, s41, 6
    v_lshlrev_b32 v7, 4, v7
    v_lshrrev_b32 v142, v7, s60
    v_lshrrev_b32 v143, 8, v142
    s_cmp_eq_u32 s57, 1
    s_cbranch_scc0 L_now1w
    s_waitcnt vmcnt(8)
L_now1w:
    s_waitcnt lgkmcnt(0)
    s_barrier
    s_cmp_eq_u32 s57, 1
    s_cbranch_scc0 L_noh
    ds_read_b64_tr_b16 v[48:49], v146 offset:0
    ds_read_b64_tr_b16 v[50:51], v146 offset:2048
    ds_read_b64_tr_b16 v[52:53], v146 offset:4096
    ds_read_b64_tr_b16 v[54:55], v146 offset:6144
    ds_read_b64_tr_b16 v[56:57], v146 offset:8192
    ds_read_b64_tr_b16 v[58:59], v146 offset:10240
    ds_read_b64_tr_b16 v[60:61], v146 offset:12288
    ds_read_b64_tr_b16 v[62:63], v146 offset:14336
    s_waitcnt lgkmcnt(6)
    v_mfma_f32_16x16x32_bf16 v[64:67], v[32:35], v[48:51], 0
    s_waitcnt lgkmcnt(4)
    v_mfma_f32_16x16x32_bf16 v[64:67], v[36:39], v[52:55], v[64:67]
    s_waitcnt lgkmcnt(2)
    v_mfma_f32_16x16x32_bf16 v[64:67], v[40:43], v[56:59], v[64:67]
    s_waitcnt lgkmcnt(0)
    v_mfma_f32_16x16x32_bf16 v[64:67], v[44:47], v[60:63], v[64:67]
    s_nop 7
    v_bfi_b32 v191, v6, v141, v64
    buffer_store_dword v191, v30, s[28:31], s85 offen
L_noh:
    ds_write_b128 v24, v[20:23]
    s_cmp_eq_u32 s57, 1
    s_cbranch_scc1 L_k4a
    v_xor_b32 v14, 16448, v14
    v_xor_b32 v15, 16448, v15
    v_xor_b32 v16, 16448, v16
    v_xor_b32 v17, 16448, v17
    s_add_u32 m0, s59, 114688
    s_nop 0
    global_load_lds_dwordx4 v14, s[38:39] offset:0 nt
    global_load_lds_dwordx4 v15, s[38:39] offset:1024 nt
    global_load_lds_dwordx4 v16, s[38:39] offset:2048 nt
    global_load_lds_dwordx4 v17, s[38:39] offset:3072 nt
    s_branch L_k4b
L_k4a:
    s_add_u32 m0, s59, 98304
    s_nop 0
    global_load_lds_dwordx4 v16, s[38:39] offset:2048 nt
    global_load_lds_dwordx4 v17, s[38:39] offset:3072 nt
    v_xor_b32 v14, 16448, v14
    v_xor_b32 v15, 16448, v15
    v_xor_b32 v16, 16448, v16
    v_xor_b32 v17, 16448, v17
    s_add_u32 m0, s59, 114688
    s_nop 0
    global_load_lds_dwordx4 v14, s[38:39] offset:0 nt
    global_load_lds_dwordx4 v15, s[38:39] offset:1024 nt
    global_load_lds_dwordx4 v16, s[38:39] offset:2048 nt
    global_load_lds_dwordx4 v17, s[38:39] offset:3072 nt
L_k4b:
    v_and_b32 v19, 31, v1
    v_lshlrev_b32 v19, 2, v19
    buffer_load_dwordx4 v[32:35], v31, s[28:31], s87 offen offset:0 sc1
    buffer_load_dwordx4 v[36:39], v31, s[28:31], s87 offen offset:256 sc1
    s_add_u32 m0, s59, 0
    s_xor_b32 s79, s58, 0
    buffer_load_dwordx4 v144, s[16:19], s79 offen offset:0 nt lds
    buffer_load_dwordx4 v145, s[16:19], s79 offen offset:1024 nt lds
    buffer_load_dwordx4 v144, s[16:19], s79 offen offset:2048 nt lds
    buffer_load_dwordx4 v145, s[16:19], s79 offen offset:3072 nt lds
    s_add_u32 m0, s59, 16384
    s_xor_b32 s79, s58, 16384
    buffer_load_dwordx4 v144, s[16:19], s79 offen offset:0 nt lds
    buffer_load_dwordx4 v145, s[16:19], s79 offen offset:1024 nt lds
    buffer_load_dwordx4 v144, s[16:19], s79 offen offset:2048 nt lds
    buffer_load_dwordx4 v145, s[16:19], s79 offen offset:3072 nt lds
    buffer_load_dwordx4 v[40:43], v31, s[28:31], s87 offen offset:0 sc1
    buffer_load_dwordx4 v[44:47], v31, s[28:31], s87 offen offset:256 sc1
    s_add_u32 m0, s59, 32768
    s_xor_b32 s79, s58, 32768
    buffer_load_dwordx4 v144, s[16:19], s79 offen offset:0 nt lds
    buffer_load_dwordx4 v145, s[16:19], s79 offen offset:1024 nt lds
    buffer_load_dwordx4 v144, s[16:19], s79 offen offset:2048 nt lds
    buffer_load_dwordx4 v145, s[16:19], s79 offen offset:3072 nt lds
    s_waitcnt vmcnt(14)
    ds_read_b128 v[64:67], v152 offset:0
    ds_read_b128 v[68:71], v153 offset:0
    ds_read_b128 v[72:75], v154 offset:0
    ds_read_b128 v[76:79], v155 offset:0
    ds_read_b128 v[80:83], v152 offset:256
    ds_read_b128 v[84:87], v153 offset:256
    ds_read_b128 v[88:91], v154 offset:256
    ds_read_b128 v[92:95], v155 offset:256
    ds_read_b128 v[96:99], v152 offset:512
    ds_read_b128 v[100:103], v153 offset:512
    ds_read_b128 v[104:107], v154 offset:512
    ds_read_b128 v[108:111], v155 offset:512
    v_xor_b32 v32, s61, v32
    v_xor_b32 v33, s62, v33
    v_xor_b32 v34, s63, v34
    v_xor_b32 v35, s64, v35
    v_xor_b32 v36, s61, v36
    v_xor_b32 v37, s62, v37
    v_xor_b32 v38, s63, v38
    v_xor_b32 v39, s64, v39
    v_or3_b32 v48, v32, v33, v34
    v_or3_b32 v48, v48, v35, v36
    v_or3_b32 v48, v48, v37, v38
    v_bitop3_b32 v48, v48, v39, v6 bitop3:0xa8
    v_cmp_ne_u32 vcc, 0, v48
    s_cbranch_vccz L_qok
    s_mov_b64 exec, vcc
    s_waitcnt vmcnt(4)
    v_mov_b32 v32, v40
    v_mov_b32 v33, v41
    v_mov_b32 v34, v42
    v_mov_b32 v35, v43
    v_mov_b32 v36, v44
    v_mov_b32 v37, v45
    v_mov_b32 v38, v46
    v_mov_b32 v39, v47
    s_branch L_qchk
L_qagain:
    s_cmp_eq_u32 s78, 3
    s_cbranch_scc0 L_qnr
    s_mov_b64 s[80:81], exec
    s_mov_b64 exec, -1
    v_lshlrev_b32 v48, 2, v1
    v_add_u32 v48, 155648, v48
    ds_read2st64_b32 v[50:51], v48 offset1:1
    ds_read2st64_b32 v[52:53], v48 offset0:2 offset1:3
    s_andn2_b32 s82, s84, 0xc0
    s_waitcnt lgkmcnt(0)
    buffer_store_dword v50, v29, s[28:31], s82 offen offset:0 sc1
    buffer_store_dword v51, v29, s[28:31], s82 offen offset:64 sc1
    buffer_store_dword v52, v29, s[28:31], s82 offen offset:128 sc1
    buffer_store_dword v53, v29, s[28:31], s82 offen offset:192 sc1
    s_mov_b64 exec, s[80:81]
L_qnr:
    buffer_load_dwordx4 v[32:35], v31, s[28:31], s87 offen offset:0 sc1
    buffer_load_dwordx4 v[36:39], v31, s[28:31], s87 offen offset:256 sc1
    s_waitcnt vmcnt(0)
L_qchk:
    v_xor_b32 v32, s61, v32
    v_xor_b32 v33, s62, v33
    v_xor_b32 v34, s63, v34
    v_xor_b32 v35, s64, v35
    v_xor_b32 v36, s61, v36
    v_xor_b32 v37, s62, v37
    v_xor_b32 v38, s63, v38
    v_xor_b32 v39, s64, v39
    v_or3_b32 v48, v32, v33, v34
    v_or3_b32 v48, v48, v35, v36
    v_or3_b32 v48, v48, v37, v38
    v_bitop3_b32 v48, v48, v39, v6 bitop3:0xa8
    v_cmp_ne_u32 vcc, 0, v48
    s_cbranch_vccz L_qok
    s_mov_b64 exec, vcc
    s_add_u32 s78, s78, 1
    s_cmp_lt_u32 s78, 200000
    s_cbranch_scc1 L_qagain
L_qok:
    s_mov_b64 exec, -1
    v_permlane32_swap_b32 v32, v36
    v_permlane32_swap_b32 v33, v37
    v_permlane32_swap_b32 v34, v38
    v_permlane32_swap_b32 v35, v39
    v_pk_add_f32 v[32:33], v[32:33], v[36:37]
    v_pk_add_f32 v[34:35], v[34:35], v[38:39]
    s_nop 1
    v_permlane16_swap_b32 v32, v34
    v_permlane16_swap_b32 v33, v35
    v_add_f32 v32, v32, v34
    v_add_f32 v33, v33, v35
    v_cvt_pk_bf16_f32 v32, v32, v33
    ds_write_b32 v156, v32
    s_waitcnt lgkmcnt(0)
    s_barrier
    ds_read_b128 v[168:171], v157 offset:0
    ds_read_b128 v[172:175], v157 offset:64
    ds_read_b128 v[176:179], v157 offset:128
    ds_read_b128 v[180:183], v157 offset:192
    ds_read_b128 v[112:115], v152 offset:768
    ds_read_b128 v[116:119], v153 offset:768
    ds_read_b128 v[120:123], v154 offset:768
    ds_read_b128 v[128:131], v155 offset:768
    s_waitcnt lgkmcnt(7)
    v_mfma_f32_16x16x32_bf16 v[48:51], v[168:171], v[64:67], 0
    v_mfma_f32_16x16x32_bf16 v[52:55], v[168:171], v[80:83], 0
    v_mfma_f32_16x16x32_bf16 v[56:59], v[168:171], v[96:99], 0
    s_waitcnt lgkmcnt(6)
    v_mfma_f32_16x16x32_bf16 v[48:51], v[172:175], v[68:71], v[48:51]
    v_mfma_f32_16x16x32_bf16 v[52:55], v[172:175], v[84:87], v[52:55]
    v_mfma_f32_16x16x32_bf16 v[56:59], v[172:175], v[100:103], v[56:59]
    s_waitcnt lgkmcnt(5)
    v_mfma_f32_16x16x32_bf16 v[48:51], v[176:179], v[72:75], v[48:51]
    v_mfma_f32_16x16x32_bf16 v[52:55], v[176:179], v[88:91], v[52:55]
    v_mfma_f32_16x16x32_bf16 v[56:59], v[176:179], v[104:107], v[56:59]
    s_waitcnt lgkmcnt(4)
    v_mfma_f32_16x16x32_bf16 v[48:51], v[180:183], v[76:79], v[48:51]
    v_mfma_f32_16x16x32_bf16 v[52:55], v[180:183], v[92:95], v[52:55]
    v_mfma_f32_16x16x32_bf16 v[56:59], v[180:183], v[108:111], v[56:59]
    s_waitcnt lgkmcnt(0)
    v_mfma_f32_16x16x32_bf16 v[60:63], v[168:171], v[112:115], 0
    v_mfma_f32_16x16x32_bf16 v[60:63], v[172:175], v[116:119], v[60:63]
    v_mfma_f32_16x16x32_bf16 v[60:63], v[176:179], v[120:123], v[60:63]
    v_mfma_f32_16x16x32_bf16 v[60:63], v[180:183], v[128:131], v[60:63]
    buffer_load_dword v18, v19, s[28:31], s92 offen offset:1024 sc1
    s_add_u32 m0, s59, 49152
    s_xor_b32 s79, s58, 49152
    buffer_load_dwordx4 v144, s[16:19], s79 offen offset:0 nt lds
    buffer_load_dwordx4 v145, s[16:19], s79 offen offset:1024 nt lds
    buffer_load_dwordx4 v144, s[16:19], s79 offen offset:2048 nt lds
    buffer_load_dwordx4 v145, s[16:19], s79 offen offset:3072 nt lds
    v_cvt_pk_bf16_f32 v53, v48, v52
    v_lshlrev_b32 v48, 16, v53
    v_and_b32 v49, 0xffff0000, v53
    v_cvt_pk_bf16_f32 v54, v56, v60
    v_lshlrev_b32 v50, 16, v54
    v_and_b32 v51, 0xffff0000, v54
    v_mul_f32 v48, 0x3db504f3, v48
    v_mul_f32 v49, 0x3db504f3, v49
    v_mul_f32 v50, 0x3db504f3, v50
    v_mul_f32 v51, 0x3db504f3, v51
    v_cvt_pk_bf16_f32 v52, v48, v49
    v_lshlrev_b32 v48, 16, v52
    v_and_b32 v49, 0xffff0000, v52
    v_cvt_pk_bf16_f32 v53, v50, v51
    v_lshlrev_b32 v50, 16, v53
    v_and_b32 v51, 0xffff0000, v53
    v_max_f32 v52, v48, v49
    v_max3_f32 v52, v52, v50, v51
    s_nop 1
    v_max_f32_dpp v52, v52, v52 quad_perm:[1,0,3,2] row_mask:0xf bank_mask:0xf
    s_nop 1
    v_max_f32_dpp v52, v52, v52 quad_perm:[2,3,0,1] row_mask:0xf bank_mask:0xf
    s_nop 1
    v_max_f32_dpp v52, v52, v52 row_half_mirror row_mask:0xf bank_mask:0xf
    s_nop 1
    v_max_f32_dpp v52, v52, v52 row_mirror row_mask:0xf bank_mask:0xf
    ds_write_b32 v9, v52
    s_mov_b32 s80, 0x3fb8aa3b
    s_waitcnt lgkmcnt(0)
    s_barrier
    ds_read_b128 v[52:55], v8
    s_waitcnt lgkmcnt(0)
    v_max_f32 v52, v52, v53
    v_max3_f32 v56, v52, v54, v55
    v_mul_f32 v52, 0xbfb8aa3b, v56
    v_fma_f32 v48, v48, s80, v52
    v_fma_f32 v49, v49, s80, v52
    v_fma_f32 v50, v50, s80, v52
    v_fma_f32 v51, v51, s80, v52
    v_exp_f32 v48, v48
    v_exp_f32 v49, v49
    v_exp_f32 v50, v50
    v_exp_f32 v51, v51
    v_add_f32 v52, v48, v49
    v_cvt_pk_bf16_f32 v54, v48, v49
    v_add_f32 v53, v50, v51
    v_cvt_pk_bf16_f32 v55, v50, v51
    v_add_f32 v52, v52, v53
    ds_write_b64 v10, v[54:55]
    s_nop 0
    v_add_f32_dpp v52, v52, v52 quad_perm:[1,0,3,2] row_mask:0xf bank_mask:0xf
    s_nop 1
    v_add_f32_dpp v52, v52, v52 quad_perm:[2,3,0,1] row_mask:0xf bank_mask:0xf
    s_nop 1
    v_add_f32_dpp v52, v52, v52 row_half_mirror row_mask:0xf bank_mask:0xf
    s_nop 1
    v_add_f32_dpp v52, v52, v52 row_mirror row_mask:0xf bank_mask:0xf
    ds_write_b32 v9, v52 offset:64
    s_cmp_eq_u32 s57, 2
    s_cbranch_scc0 L_sw1
    buffer_load_dwordx4 v[132:135], v12, s[28:31], s90 offen offset:0 sc1
    buffer_load_dwordx4 v[136:139], v12, s[28:31], s90 offen offset:64 sc1
    s_add_u32 m0, s59, 131072
    s_nop 0
    buffer_load_dwordx4 v188, s[24:27], s91 offen offset:0 nt lds
    s_add_i32 s91, s91, 15360
    buffer_load_dwordx4 v188, s[24:27], s91 offen offset:1024 nt lds
    s_add_i32 s91, s91, -9216
    buffer_load_dwordx4 v188, s[24:27], s91 offen offset:2048 nt lds
    s_add_i32 s91, s91, 15360
    buffer_load_dwordx4 v188, s[24:27], s91 offen offset:3072 nt lds
    s_branch L_sw2
L_sw1:
    s_add_u32 m0, s59, 114688
    s_nop 0
    buffer_load_dwordx4 v13, s[20:23], s89 offen offset:0 nt lds
    s_add_i32 s89, s89, 7168
    buffer_load_dwordx4 v13, s[20:23], s89 offen offset:1024 nt lds
    s_add_i32 s89, s89, -5120
    buffer_load_dwordx4 v13, s[20:23], s89 offen offset:2048 nt lds
    s_add_i32 s89, s89, 7168
    buffer_load_dwordx4 v13, s[20:23], s89 offen offset:3072 nt lds
L_sw2:
    s_cmp_eq_u32 s57, 2
    s_cbranch_scc0 L_now2l
    s_add_u32 m0, s59, 114688
    s_nop 0
    buffer_load_dwordx4 v13, s[20:23], s89 offen offset:0 nt lds
    s_add_i32 s89, s89, 7168
    buffer_load_dwordx4 v13, s[20:23], s89 offen offset:1024 nt lds
    s_add_i32 s89, s89, -5120
    buffer_load_dwordx4 v13, s[20:23], s89 offen offset:2048 nt lds
    s_add_i32 s89, s89, 7168
    buffer_load_dwordx4 v13, s[20:23], s89 offen offset:3072 nt lds
L_now2l:
    s_cmp_eq_u32 s57, 2
    s_cbranch_scc1 L_w012
    s_waitcnt vmcnt(8)
L_w012:
    s_waitcnt vmcnt(14) lgkmcnt(0)
    s_barrier
    ds_read_b128 v[60:63], v8 offset:64
    ds_read_b128 v[64:67], v11 offset:0
    ds_read_b64_tr_b16 v[96:97], v27 offset:0
    ds_read_b64_tr_b16 v[98:99], v27 offset:4096
    ds_read_b64_tr_b16 v[100:101], v28 offset:0
    ds_read_b64_tr_b16 v[102:103], v28 offset:4096
    ds_read_b128 v[68:71], v11 offset:64
    ds_read_b64_tr_b16 v[104:105], v27 offset:8192
    ds_read_b64_tr_b16 v[106:107], v27 offset:12288
    ds_read_b64_tr_b16 v[108:109], v28 offset:8192
    ds_read_b64_tr_b16 v[110:111], v28 offset:12288
    v_mov_b32 v58, s60
    v_mov_b32 v59, s60
    s_lshl_b32 s80, s52, 4
    s_waitcnt lgkmcnt(10)
    v_cmp_ne_u32 vcc, s70, v18
    s_cmp_lg_u64 vcc, 0
    s_cselect_b32 s69, 1, 0
    s_cbranch_scc0 L_norep
    buffer_store_dword v190, v29, s[28:31], s84 offen sc1
    s_cmp_eq_u32 s57, 1
    s_cbranch_scc0 L_norep
    buffer_store_dword v191, v30, s[28:31], s85 offen sc1
L_norep:
    v_add_f32 v60, v60, v61
    v_add_f32 v62, v62, v63
    ds_read_b128 v[72:75], v11 offset:128
    ds_read_b64_tr_b16 v[112:113], v27 offset:16384
    ds_read_b64_tr_b16 v[114:115], v27 offset:20480
    ds_read_b64_tr_b16 v[116:117], v28 offset:16384
    ds_read_b64_tr_b16 v[118:119], v28 offset:20480
    v_add_f32 v57, v60, v62
    s_lshl_b64 exec, 1, s80
    s_cmp_eq_u32 s69, 0
    s_cbranch_scc1 L_ss_f
    buffer_store_dwordx4 v[56:59], v160, s[28:31], s36 offen sc1
    s_branch L_ss_e
L_ss_f:
    buffer_store_dwordx4 v[56:59], v160, s[28:31], s36 offen
L_ss_e:
    s_mov_b64 exec, -1
    s_waitcnt lgkmcnt(10)
    v_mfma_f32_16x16x32_bf16 v[40:43], v[64:67], v[96:99], 0
    v_mfma_f32_16x16x32_bf16 v[44:47], v[64:67], v[100:103], 0
    ds_read_b128 v[76:79], v11 offset:192
    ds_read_b64_tr_b16 v[96:97], v27 offset:24576
    ds_read_b64_tr_b16 v[98:99], v27 offset:28672
    ds_read_b64_tr_b16 v[100:101], v28 offset:24576
    ds_read_b64_tr_b16 v[102:103], v28 offset:28672
    s_waitcnt lgkmcnt(10)
    v_mfma_f32_16x16x32_bf16 v[40:43], v[68:71], v[104:107], v[40:43]
    v_mfma_f32_16x16x32_bf16 v[44:47], v[68:71], v[108:111], v[44:47]
    ds_read_b128 v[80:83], v11 offset:256
    ds_read_b64_tr_b16 v[104:105], v27 offset:32768
    ds_read_b64_tr_b16 v[106:107], v27 offset:36864
    ds_read_b64_tr_b16 v[108:109], v28 offset:32768
    ds_read_b64_tr_b16 v[110:111], v28 offset:36864
    s_waitcnt lgkmcnt(10)
    v_mfma_f32_16x16x32_bf16 v[40:43], v[72:75], v[112:115], v[40:43]
    v_mfma_f32_16x16x32_bf16 v[44:47], v[72:75], v[116:119], v[44:47]
    ds_read_b128 v[84:87], v11 offset:320
    ds_read_b64_tr_b16 v[112:113], v27 offset:40960
    ds_read_b64_tr_b16 v[114:115], v27 offset:45056
    ds_read_b64_tr_b16 v[116:117], v28 offset:40960
    ds_read_b64_tr_b16 v[118:119], v28 offset:45056
    s_waitcnt lgkmcnt(10)
    v_mfma_f32_16x16x32_bf16 v[40:43], v[76:79], v[96:99], v[40:43]
    v_mfma_f32_16x16x32_bf16 v[44:47], v[76:79], v[100:103], v[44:47]
    ds_read_b128 v[88:91], v11 offset:384
    ds_read_b128 v[92:95], v11 offset:448
    s_waitcnt lgkmcnt(7)
    v_mfma_f32_16x16x32_bf16 v[40:43], v[80:83], v[104:107], v[40:43]
    v_mfma_f32_16x16x32_bf16 v[44:47], v[80:83], v[108:111], v[44:47]
    s_waitcnt lgkmcnt(2)
    v_mfma_f32_16x16x32_bf16 v[40:43], v[84:87], v[112:115], v[40:43]
    v_mfma_f32_16x16x32_bf16 v[44:47], v[84:87], v[116:119], v[44:47]
    buffer_load_dwordx4 v[184:187], v159, s[28:31], s46 offen sc1
    s_cmp_eq_u32 s57, 2
    s_cbranch_scc1 L_w3
    s_waitcnt vmcnt(6)
L_w3:
    s_waitcnt vmcnt(12)
L_gdone:
    s_barrier
    ds_read_b64_tr_b16 v[96:97], v27 offset:49152
    ds_read_b64_tr_b16 v[98:99], v27 offset:53248
    ds_read_b64_tr_b16 v[100:101], v28 offset:49152
    ds_read_b64_tr_b16 v[102:103], v28 offset:53248
    ds_read_b64_tr_b16 v[104:105], v27 offset:57344
    ds_read_b64_tr_b16 v[106:107], v27 offset:61440
    ds_read_b64_tr_b16 v[108:109], v28 offset:57344
    ds_read_b64_tr_b16 v[110:111], v28 offset:61440
    s_waitcnt lgkmcnt(4)
    v_mfma_f32_16x16x32_bf16 v[40:43], v[88:91], v[96:99], v[40:43]
    v_mfma_f32_16x16x32_bf16 v[44:47], v[88:91], v[100:103], v[44:47]
    s_waitcnt lgkmcnt(0)
    v_mfma_f32_16x16x32_bf16 v[40:43], v[92:95], v[104:107], v[40:43]
    v_mfma_f32_16x16x32_bf16 v[44:47], v[92:95], v[108:111], v[44:47]
    s_nop 6
    v_bfi_b32 v48, v6, v142, v40
    v_bfi_b32 v49, v6, v143, v44
    s_cmp_eq_u32 s69, 0
    s_cbranch_scc1 L_os_f
    buffer_store_dwordx2 v[48:49], v158, s[28:31], s37 offen sc1
    s_branch L_os_e
L_os_f:
    buffer_store_dwordx2 v[48:49], v158, s[28:31], s37 offen
L_os_e:
    s_cmp_eq_u32 s57, 2
    s_cbranch_scc0 L_noffn
    s_waitcnt vmcnt(7)
    ds_read_b64_tr_b16 v[80:81], v148 offset:16384
    ds_read_b64_tr_b16 v[82:83], v148 offset:18432
    ds_read_b64_tr_b16 v[84:85], v149 offset:16384
    ds_read_b64_tr_b16 v[86:87], v149 offset:18432
    ds_read_b64_tr_b16 v[88:89], v150 offset:16384
    ds_read_b64_tr_b16 v[90:91], v150 offset:18432
    ds_read_b64_tr_b16 v[92:93], v151 offset:16384
    ds_read_b64_tr_b16 v[94:95], v151 offset:18432
    s_branch L_hchk
L_hagain:
    buffer_load_dwordx4 v[132:135], v12, s[28:31], s90 offen offset:0 sc1
    buffer_load_dwordx4 v[136:139], v12, s[28:31], s90 offen offset:64 sc1
    s_waitcnt vmcnt(0)
L_hchk:
    v_xor_b32 v132, s61, v132
    v_xor_b32 v133, s62, v133
    v_xor_b32 v134, s63, v134
    v_xor_b32 v135, s64, v135
    v_xor_b32 v136, s61, v136
    v_xor_b32 v137, s62, v137
    v_xor_b32 v138, s63, v138
    v_xor_b32 v139, s64, v139
    v_or3_b32 v140, v132, v133, v134
    v_or3_b32 v140, v140, v135, v136
    v_or3_b32 v140, v140, v137, v138
    v_bitop3_b32 v140, v140, v139, v6 bitop3:0xa8
    v_cmp_ne_u32 vcc, 0, v140
    s_cbranch_vccz L_hok
    s_mov_b64 exec, vcc
    s_add_u32 s78, s78, 1
    s_cmp_lt_u32 s78, 200000
    s_cbranch_scc1 L_hagain
L_hok:
    s_mov_b64 exec, -1
    v_permlane32_swap_b32 v132, v136
    v_permlane32_swap_b32 v133, v137
    v_permlane32_swap_b32 v134, v138
    v_permlane32_swap_b32 v135, v139
    v_pk_add_f32 v[132:133], v[132:133], v[136:137]
    v_pk_add_f32 v[134:135], v[134:135], v[138:139]
    s_nop 1
    v_permlane16_swap_b32 v132, v134
    v_permlane16_swap_b32 v133, v135
    v_add_f32 v132, v132, v134
    v_add_f32 v133, v133, v135
    v_max_f32 v132, 0, v132
    v_max_f32 v133, 0, v133
    v_cvt_pk_bf16_f32 v132, v132, v133
    s_nop 1
    v_mov_b32_dpp v136, v132 quad_perm:[0,0,0,0] row_mask:0xf bank_mask:0xf
    v_mov_b32_dpp v137, v132 quad_perm:[1,1,1,1] row_mask:0xf bank_mask:0xf
    v_mov_b32_dpp v138, v132 quad_perm:[2,2,2,2] row_mask:0xf bank_mask:0xf
    v_mov_b32_dpp v139, v132 quad_perm:[3,3,3,3] row_mask:0xf bank_mask:0xf
    s_waitcnt lgkmcnt(0)
    s_nop 0
    v_mfma_f32_16x16x32_bf16 v[32:35], v[136:139], v[80:83], 0
    v_mfma_f32_16x16x32_bf16 v[36:39], v[136:139], v[84:87], 0
    v_mfma_f32_16x16x32_bf16 v[40:43], v[136:139], v[88:91], 0
    v_mfma_f32_16x16x32_bf16 v[44:47], v[136:139], v[92:95], 0
    s_nop 5
    ds_write2_b32 v161, v32, v36 offset0:0 offset1:16
    s_nop 0
    ds_write2_b32 v161, v40, v44 offset0:32 offset1:48
L_noffn:
    buffer_load_dwordx4 v[56:59], v159, s[28:31], s46 offen sc1
    buffer_load_dwordx4 v[64:67], v12, s[28:31], s88 offen offset:0 sc1
    buffer_load_dwordx4 v[68:71], v12, s[28:31], s88 offen offset:64 sc1
    buffer_load_dwordx4 v[72:75], v12, s[28:31], s88 offen offset:512 sc1
    buffer_load_dwordx4 v[76:79], v12, s[28:31], s88 offen offset:576 sc1
    s_waitcnt vmcnt(6)
    v_bitop3_b32 v186, v186, v187, s60 bitop3:0x7e
    v_cmp_ne_u32 vcc, 0, v186
    ds_read_b64_tr_b16 v[96:97], v148 offset:0
    ds_read_b64_tr_b16 v[98:99], v148 offset:2048
    ds_read_b64_tr_b16 v[100:101], v149 offset:0
    ds_read_b64_tr_b16 v[102:103], v149 offset:2048
    ds_read_b64_tr_b16 v[104:105], v150 offset:0
    ds_read_b64_tr_b16 v[106:107], v150 offset:2048
    ds_read_b64_tr_b16 v[108:109], v151 offset:0
    ds_read_b64_tr_b16 v[110:111], v151 offset:2048
    s_cbranch_vccz L_sok2
    s_mov_b64 exec, vcc
    s_waitcnt vmcnt(4)
    v_mov_b32 v184, v56
    v_mov_b32 v185, v57
    v_mov_b32 v186, v58
    v_mov_b32 v187, v59
    v_bitop3_b32 v186, v186, v187, s60 bitop3:0x7e
    v_cmp_ne_u32 vcc, 0, v186
    s_cbranch_vccz L_sok1
    s_mov_b64 exec, vcc
L_sagain:
    buffer_load_dwordx4 v[184:187], v159, s[28:31], s46 offen sc1
    s_waitcnt vmcnt(0)
    v_bitop3_b32 v186, v186, v187, s60 bitop3:0x7e
    v_cmp_ne_u32 vcc, 0, v186
    s_cbranch_vccz L_sok
    s_mov_b64 exec, vcc
    s_add_u32 s78, s78, 1
    s_cmp_lt_u32 s78, 200000
    s_cbranch_scc1 L_sagain
L_sok:
    s_mov_b64 exec, -1
    buffer_load_dwordx4 v[64:67], v12, s[28:31], s88 offen offset:0 sc1
    buffer_load_dwordx4 v[68:71], v12, s[28:31], s88 offen offset:64 sc1
    buffer_load_dwordx4 v[72:75], v12, s[28:31], s88 offen offset:512 sc1
    buffer_load_dwordx4 v[76:79], v12, s[28:31], s88 offen offset:576 sc1
L_sok1:
    s_mov_b64 exec, -1
L_sok2:
    v_max_f32_dpp v60, v184, v184 quad_perm:[1,0,3,2] row_mask:0xf bank_mask:0xf
    v_mov_b32 v61, v60
    s_nop 1
    v_permlane16_swap_b32 v60, v61
    v_max_f32 v60, v60, v61
    v_mov_b32 v61, v60
    s_nop 1
    v_permlane32_swap_b32 v60, v61
    v_max_f32 v60, v60, v61
    v_sub_f32 v60, v184, v60
    v_mul_f32 v60, 0x3fb8aa3b, v60
    v_exp_f32 v60, v60
    s_nop 0
    v_mul_f32 v61, v60, v185
    s_nop 1
    v_add_f32_dpp v61, v61, v61 quad_perm:[1,0,3,2] row_mask:0xf bank_mask:0xf
    v_mov_b32 v62, v61
    s_nop 1
    v_permlane16_swap_b32 v61, v62
    v_add_f32 v61, v61, v62
    v_mov_b32 v62, v61
    s_nop 1
    v_permlane32_swap_b32 v61, v62
    v_add_f32 v61, v61, v62
    v_rcp_f32 v61, v61
    s_nop 0
    v_mul_f32 v60, v60, v61
    s_nop 1
    v_mov_b32_dpp v62, v60 quad_perm:[0,0,0,0] row_mask:0xf bank_mask:0xf
    v_mov_b32_dpp v63, v60 quad_perm:[1,1,1,1] row_mask:0xf bank_mask:0xf
    s_branch L_ow
L_oagain:
    buffer_load_dwordx4 v[64:67], v12, s[28:31], s88 offen offset:0 sc1
    buffer_load_dwordx4 v[68:71], v12, s[28:31], s88 offen offset:64 sc1
    buffer_load_dwordx4 v[72:75], v12, s[28:31], s88 offen offset:512 sc1
    buffer_load_dwordx4 v[76:79], v12, s[28:31], s88 offen offset:576 sc1
L_ow:
    s_waitcnt vmcnt(2)
    v_xor_b32 v64, s61, v64
    v_xor_b32 v65, s62, v65
    v_xor_b32 v66, s63, v66
    v_xor_b32 v67, s64, v67
    v_or3_b32 v61, v64, v65, v66
    v_xor_b32 v68, s61, v68
    v_xor_b32 v69, s62, v69
    v_xor_b32 v70, s63, v70
    v_xor_b32 v71, s64, v71
    v_or3_b32 v61, v61, v67, v68
    v_or3_b32 v61, v61, v69, v70
    s_waitcnt vmcnt(1)
    v_xor_b32 v72, s61, v72
    v_xor_b32 v73, s62, v73
    v_xor_b32 v74, s63, v74
    v_xor_b32 v75, s64, v75
    v_or3_b32 v61, v61, v71, v72
    v_or3_b32 v61, v61, v73, v74
    s_waitcnt vmcnt(0)
    v_xor_b32 v76, s61, v76
    v_xor_b32 v77, s62, v77
    v_xor_b32 v78, s63, v78
    v_xor_b32 v79, s64, v79
    v_or3_b32 v61, v61, v75, v76
    v_or3_b32 v61, v61, v77, v78
    v_bitop3_b32 v61, v61, v79, v6 bitop3:0xa8
    v_cmp_ne_u32 vcc, 0, v61
    s_cbranch_vccz L_ook
    s_mov_b64 exec, vcc
    s_add_u32 s78, s78, 1
    s_cmp_lt_u32 s78, 200000
    s_cbranch_scc1 L_oagain
L_ook:
    s_mov_b64 exec, -1
    v_pk_mul_f32 v[64:65], v[64:65], v[62:63] op_sel_hi:[1,0]
    v_pk_mul_f32 v[66:67], v[66:67], v[62:63] op_sel_hi:[1,0]
    v_pk_mul_f32 v[68:69], v[68:69], v[62:63] op_sel_hi:[1,0]
    v_pk_mul_f32 v[70:71], v[70:71], v[62:63] op_sel_hi:[1,0]
    v_pk_fma_f32 v[64:65], v[72:73], v[62:63], v[64:65] op_sel:[0,1,0]
    v_pk_fma_f32 v[66:67], v[74:75], v[62:63], v[66:67] op_sel:[0,1,0]
    v_pk_fma_f32 v[68:69], v[76:77], v[62:63], v[68:69] op_sel:[0,1,0]
    v_pk_fma_f32 v[70:71], v[78:79], v[62:63], v[70:71] op_sel:[0,1,0]
    s_nop 0
    v_permlane32_swap_b32 v64, v68
    v_permlane32_swap_b32 v65, v69
    v_permlane32_swap_b32 v66, v70
    v_permlane32_swap_b32 v67, v71
    v_pk_add_f32 v[64:65], v[64:65], v[68:69]
    v_pk_add_f32 v[66:67], v[66:67], v[70:71]
    s_nop 0
    v_permlane16_swap_b32 v64, v65
    v_permlane16_swap_b32 v66, v67
    v_add_f32 v64, v64, v65
    v_add_f32 v65, v66, v67
    v_cvt_pk_bf16_f32 v64, v64, v65
    s_nop 1
    v_mov_b32_dpp v68, v64 quad_perm:[0,0,0,0] row_mask:0xf bank_mask:0xf
    v_mov_b32_dpp v69, v64 quad_perm:[1,1,1,1] row_mask:0xf bank_mask:0xf
    v_mov_b32_dpp v70, v64 quad_perm:[2,2,2,2] row_mask:0xf bank_mask:0xf
    v_mov_b32_dpp v71, v64 quad_perm:[3,3,3,3] row_mask:0xf bank_mask:0xf
    s_waitcnt lgkmcnt(0)
    s_nop 0
    v_mfma_f32_16x16x32_bf16 v[32:35], v[68:71], v[96:99], 0
    v_mfma_f32_16x16x32_bf16 v[36:39], v[68:71], v[100:103], 0
    v_mfma_f32_16x16x32_bf16 v[40:43], v[68:71], v[104:107], 0
    v_mfma_f32_16x16x32_bf16 v[44:47], v[68:71], v[108:111], 0
    s_nop 5
    ds_write2_b32 v147, v32, v36 offset0:0 offset1:16
    s_nop 0
    ds_write2_b32 v147, v40, v44 offset0:32 offset1:48
    v_add_u32 v165, s59, v165
    s_cmp_eq_u32 s52, 0
    s_cselect_b32 s47, s47, s40
    s_cmp_ge_u32 s52, 2
    s_waitcnt lgkmcnt(0)
    s_barrier
    s_cbranch_scc1 L_final
    s_lshl_b32 s80, s52, 1
    s_andn2_b32 s80, s80, s57
    s_cbranch_scc1 L_done
    ds_read_b128 v[32:35], v165 offset:0
    ds_read_b128 v[36:39], v165 offset:1024
    ds_read_b128 v[40:43], v165 offset:2048
    ds_read_b128 v[44:47], v165 offset:3072
    s_waitcnt lgkmcnt(2)
    v_pk_add_f32 v[32:33], v[32:33], v[36:37]
    v_pk_add_f32 v[34:35], v[34:35], v[38:39]
    s_waitcnt lgkmcnt(0)
    v_pk_add_f32 v[40:41], v[40:41], v[44:45]
    v_pk_add_f32 v[42:43], v[42:43], v[46:47]
    v_pk_add_f32 v[32:33], v[32:33], v[40:41]
    v_pk_add_f32 v[34:35], v[34:35], v[42:43]
    v_bfi_b32 v32, v6, s61, v32
    v_bfi_b32 v33, v6, s62, v33
    v_bfi_b32 v34, v6, s63, v34
    v_bfi_b32 v35, v6, s64, v35
    buffer_store_dwordx4 v[32:35], v166, s[28:31], s47 offen sc1
    s_branch L_done
L_final:
L_tkagain:
    v_mov_b32 v60, 1
    s_mov_b64 exec, 1
    buffer_atomic_add v60, v160, s[28:31], s45 offen sc0 sc1
    s_mov_b64 exec, -1
L_tkw:
    s_waitcnt vmcnt(0)
L_tkr:
    v_readfirstlane_b32 s41, v60
    s_xor_b32 s41, s41, s44
    s_cmp_lt_u32 s41, 32
    s_cbranch_scc1 L_tkok
    s_add_u32 s78, s78, 1
    s_cmp_lt_u32 s78, 200000
    s_cbranch_scc1 L_tkagain
    s_branch L_done
L_tkok:
    s_sub_u32 s41, s41, 28
    s_cbranch_scc1 L_done
    s_lshl_b32 s41, s41, 4
    s_bfe_u32 s80, s45, 0x40007
    s_add_u32 s41, s41, s80
    s_mul_i32 s42, s41, 6144
    s_add_u32 s42, s42, 1048576
    s_add_u32 s43, s42, 4096
    s_lshl_b32 s83, s41, 6
    s_lshr_b32 s80, s41, 4
    s_lshl_b32 s80, s80, 6
    s_add_u32 s80, s80, s83
    s_add_u32 s80, s80, 147456
    v_add_u32 v62, s80, v167
    buffer_load_dwordx4 v[48:51], v164, s[28:31], s43 offen sc1
    v_mov_b32 v52, s61
    v_mov_b32 v53, s62
    v_mov_b32 v54, s63
    v_mov_b32 v55, s64
    s_mov_b32 s80, exec_hi
    s_and_b32 exec_hi, exec_hi, 0xffff
    s_cbranch_execz L_gs1
    buffer_load_dwordx4 v[52:55], v164, s[28:31], s43 offen offset:1024 sc1
L_gs1:
    s_mov_b32 exec_hi, s80
    buffer_load_dwordx4 v[32:35], v164, s[28:31], s42 offen offset:0 sc1
    buffer_load_dwordx4 v[36:39], v164, s[28:31], s42 offen offset:1024 sc1
    buffer_load_dwordx4 v[40:43], v164, s[28:31], s42 offen offset:2048 sc1
    buffer_load_dwordx4 v[44:47], v164, s[28:31], s42 offen offset:3072 sc1
    ds_read_u16 v60, v62
    s_waitcnt vmcnt(4) lgkmcnt(0)
    s_branch L_gchk
L_gagain:
    buffer_load_dwordx4 v[48:51], v164, s[28:31], s43 offen sc1
    v_mov_b32 v52, s61
    v_mov_b32 v53, s62
    v_mov_b32 v54, s63
    v_mov_b32 v55, s64
    s_mov_b32 s80, exec_hi
    s_and_b32 exec_hi, exec_hi, 0xffff
    s_cbranch_execz L_gs2
    buffer_load_dwordx4 v[52:55], v164, s[28:31], s43 offen offset:1024 sc1
L_gs2:
    s_mov_b32 exec_hi, s80
    s_waitcnt vmcnt(0)
L_gchk:
    v_xor_b32 v48, s61, v48
    v_xor_b32 v49, s62, v49
    v_xor_b32 v50, s63, v50
    v_xor_b32 v51, s64, v51
    v_xor_b32 v52, s61, v52
    v_xor_b32 v53, s62, v53
    v_xor_b32 v54, s63, v54
    v_xor_b32 v55, s64, v55
    v_or3_b32 v61, v48, v49, v50
    v_or3_b32 v61, v61, v51, v52
    v_or3_b32 v61, v61, v53, v54
    v_bitop3_b32 v61, v61, v55, v6 bitop3:0xa8
    v_cmp_ne_u32 vcc, 0, v61
    s_cbranch_vccz L_gok
    s_mov_b64 exec, vcc
    s_add_u32 s78, s78, 1
    s_cmp_lt_u32 s78, 200000
    s_cbranch_scc1 L_gagain
L_gok:
    s_mov_b64 exec, -1
    v_pk_add_f32 v[48:49], v[48:49], v[52:53]
    v_pk_add_f32 v[50:51], v[50:51], v[54:55]
    v_lshlrev_b32 v60, 16, v60
    s_nop 0
    v_permlane32_swap_b32 v48, v50
    v_permlane32_swap_b32 v49, v51
    v_pk_add_f32 v[48:49], v[48:49], v[50:51]
    s_nop 1
    v_permlane16_swap_b32 v48, v49
    v_add_f32 v48, v48, v49
    s_nop 1
    v_add_f32_dpp v48, v48, v48 row_ror:8 row_mask:0xf bank_mask:0xf
    v_cvt_pk_bf16_f32 v48, v48, v48
    v_and_b32 v48, 0xffff0000, v48
    v_mul_f32 v49, 0xbfb8aa3b, v48
    v_exp_f32 v49, v49
    s_nop 0
    v_add_f32 v49, 1.0, v49
    v_rcp_f32 v49, v49
    s_nop 0
    v_mul_f32 v48, v48, v49
    v_cvt_pk_bf16_f32 v48, v48, v48
    v_and_b32 v48, 0xffff0000, v48
    s_branch L_fchk
L_fagain:
    buffer_load_dwordx4 v[32:35], v164, s[28:31], s42 offen offset:0 sc1
    buffer_load_dwordx4 v[36:39], v164, s[28:31], s42 offen offset:1024 sc1
    buffer_load_dwordx4 v[40:43], v164, s[28:31], s42 offen offset:2048 sc1
    buffer_load_dwordx4 v[44:47], v164, s[28:31], s42 offen offset:3072 sc1
L_fchk:
    s_waitcnt vmcnt(2)
    v_xor_b32 v32, s61, v32
    v_xor_b32 v33, s62, v33
    v_xor_b32 v34, s63, v34
    v_xor_b32 v35, s64, v35
    v_or3_b32 v61, v32, v33, v34
    v_xor_b32 v36, s61, v36
    v_xor_b32 v37, s62, v37
    v_xor_b32 v38, s63, v38
    v_xor_b32 v39, s64, v39
    v_or3_b32 v61, v61, v35, v36
    v_or3_b32 v61, v61, v37, v38
    s_waitcnt vmcnt(1)
    v_xor_b32 v40, s61, v40
    v_xor_b32 v41, s62, v41
    v_xor_b32 v42, s63, v42
    v_xor_b32 v43, s64, v43
    v_or3_b32 v61, v61, v39, v40
    v_or3_b32 v61, v61, v41, v42
    s_waitcnt vmcnt(0)
    v_xor_b32 v44, s61, v44
    v_xor_b32 v45, s62, v45
    v_xor_b32 v46, s63, v46
    v_xor_b32 v47, s64, v47
    v_or3_b32 v61, v61, v43, v44
    v_or3_b32 v61, v61, v45, v46
    v_bitop3_b32 v61, v61, v47, v6 bitop3:0xa8
    v_cmp_ne_u32 vcc, 0, v61
    s_cbranch_vccz L_fok
    s_mov_b64 exec, vcc
    s_add_u32 s78, s78, 1
    s_cmp_lt_u32 s78, 200000
    s_cbranch_scc1 L_fagain
L_fok:
    s_mov_b64 exec, -1
    v_pk_add_f32 v[32:33], v[32:33], v[40:41]
    v_pk_add_f32 v[34:35], v[34:35], v[42:43]
    v_pk_add_f32 v[36:37], v[36:37], v[44:45]
    v_pk_add_f32 v[38:39], v[38:39], v[46:47]
    v_pk_add_f32 v[32:33], v[32:33], v[36:37]
    v_pk_add_f32 v[34:35], v[34:35], v[38:39]
    s_nop 1
    v_permlane32_swap_b32 v32, v34
    v_permlane32_swap_b32 v33, v35
    v_pk_add_f32 v[32:33], v[32:33], v[34:35]
    s_nop 1
    v_permlane16_swap_b32 v32, v33
    v_add_f32 v32, v32, v33
    s_nop 1
    v_add_f32_dpp v32, v32, v32 row_ror:8 row_mask:0xf bank_mask:0xf
    v_cvt_pk_bf16_f32 v32, v32, v32
    v_and_b32 v32, 0xffff0000, v32
    v_mul_f32 v32, v32, v48
    v_cvt_pk_bf16_f32 v32, v32, v32
    v_and_b32 v32, 0xffff0000, v32
    v_add_f32 v32, v60, v32
    v_cvt_pk_bf16_f32 v32, v32, v32
    s_mov_b32 exec_lo, 0x00ff00ff
    s_mov_b32 exec_hi, 0x00ff00ff
    buffer_store_short v32, v167, s[32:35], s83 offen
    s_cmp_eq_u32 s41, 0
    s_cbranch_scc0 L_done
    v_mov_b32 v33, s60
    s_mov_b64 exec, 1
    buffer_store_dword v33, v160, s[28:31], 0 offen
L_done:
L_end:
    s_endpgm
.fill 9472 - (. - recurrent_scan__sliding_block_cached__dense_activation_relu__decode_kernel), 1, 0
.section .rodata,"a"
.p2align 6
.amdhsa_kernel recurrent_scan__sliding_block_cached__dense_activation_relu__decode_kernel
  .amdhsa_next_free_vgpr 192
  .amdhsa_next_free_sgpr 102
  .amdhsa_accum_offset 192
  .amdhsa_group_segment_fixed_size 0
  .amdhsa_kernarg_size 88
  .amdhsa_user_sgpr_count 2
  .amdhsa_user_sgpr_kernarg_segment_ptr 1
  .amdhsa_system_sgpr_workgroup_id_x 1
.end_amdhsa_kernel
```
